```python
import torch

def _softmax(x, axis=-1):
    return torch.softmax(x, dim=axis)
def _gelu(x):
    return torch.nn.functional.gelu(x, approximate="tanh")
def _silu(x):
    return torch.nn.functional.silu(x)
def _sigmoid(x):
    return torch.sigmoid(x)
def _layernorm(x, axis=-1, eps=1e-5):
    m = x.mean(dim=axis, keepdim=True)
    v = x.var(dim=axis, keepdim=True, unbiased=False)
    return (x - m) / torch.sqrt(v + eps)
def _scatter_add(tgt, idx, src, axis=0):
    return tgt.clone().index_add_(axis, idx, src)
def _segment_sum(src, seg, n):
    out = torch.zeros((n,) + src.shape[1:], dtype=src.dtype)
    return out.index_add_(0, seg, src)
def _pad(x, pw):
    flat = tuple(v for pair in reversed(pw) for v in pair)
    return torch.nn.functional.pad(x, flat)

kernel_name = 'standalone__kernel_systems_refs_featgraph__graph'

def setup_inputs():

    _w = (lambda a: (lambda t: t.to(torch.bfloat16) if t.is_floating_point() else t)(torch.as_tensor(a)))
    N, deg, D = 12500, 32, 128
    E = N * deg
    scale = D ** -0.5
    src = (lambda lo, hi, *s: torch.randint(lo, hi, s))(0, N, E).to(torch.int64)
    dst = (lambda lo, hi, *s: torch.randint(lo, hi, s))(0, N, E).to(torch.int64)
    return {
        "x": _w((lambda *s: torch.randn(*s, dtype=torch.bfloat16) * 0.8)(N, D)),
        "src": _w(src),
        "dst": _w(dst),
        "w_q": _w((lambda *s: torch.randn(*s, dtype=torch.bfloat16) * 0.8)(D, D) * scale),
        "w_v": _w((lambda *s: torch.randn(*s, dtype=torch.bfloat16) * 0.05)(D, D) * scale),
    }

def reference(x, src, dst, w_q, w_v):
    N, D = x.shape
    xs = x[src]
    xd = x[dst]
    q = xd @ w_q
    logits = torch.einsum('ed,ed->e', xs, q) * (float(D) ** -0.5)
    alpha = _sigmoid(logits)
    msg = alpha[:, None] * (xs @ w_v)
    return _segment_sum(msg, dst, N)
```

```asm
; @launch grid=(250,1,1) block=(1024,1,1) lds=148736
.amdgcn_target "amdgcn-amd-amdhsa--gfx950"
.text
.p2align 8
.globl standalone__kernel_systems_refs_featgraph__graph_kernel
.type standalone__kernel_systems_refs_featgraph__graph_kernel,@function
standalone__kernel_systems_refs_featgraph__graph_kernel:
    s_cmp_ge_u32 s2, 250
    s_cbranch_scc1 k_end
    s_load_dwordx16 s[4:19], s[0:1], 0
    v_lshlrev_b32 v1, 4, v0
    v_lshrrev_b32 v99, 6, v0
    v_and_b32 v2, 15, v0
    v_readfirstlane_b32 s36, v99
    v_bfe_u32 v3, v0, 4, 2
    s_mul_i32 s42, s2, 12800
    s_and_b32 s80, s2, 7
    s_lshl_b32 s80, s80, 2
    s_lshr_b32 s80, 1985229328, s80
    s_and_b32 s80, s80, 15
    s_lshr_b32 s3, s2, 3
    s_mulk_i32 s3, 8
    s_add_u32 s3, s3, s80
    s_cmp_eq_u32 s80, 15
    s_cselect_b32 s3, 255, s3
    s_mul_i32 s79, s3, 12800
    v_cmp_gt_u32 vcc, 400, v0
    v_add_u32 v100, s79, v1
    v_add_u32 v98, 6400, v100
    s_mov_b64 s[52:53], vcc
    s_waitcnt lgkmcnt(0)
    s_cmp_lt_u32 s3, 125
    s_cbranch_scc0 k_noedge
    s_mov_b64 exec, s[52:53]
    s_cbranch_execz k_noedge
    global_load_dwordx4 v[12:15], v100, s[8:9] nt
    global_load_dwordx4 v[16:19], v98, s[8:9] nt
k_noedge:
    s_mov_b64 exec, -1
    s_cmp_lt_u32 s36, 14
    s_cbranch_scc1 k_i0
    v_mov_b32 v84, 0
    v_mov_b32 v85, 0
    v_mov_b32 v86, 0
    v_mov_b32 v87, 0
    v_and_b32 v99, 0x7ff, v1
    ds_write_b128 v99, v[84:87]
    s_waitcnt lgkmcnt(0)
k_i0:
    s_load_dword s37, s[18:19], 0
    s_mov_b32 s20, s4
    s_mov_b32 s21, s5
    s_mov_b32 s22, 3200000
    s_mov_b32 s23, 0x20000
    v_mov_b32 v101, 4
    s_barrier
    s_cmp_ge_u32 s36, 8
    s_cbranch_scc1 k_aux0
    s_mul_i32 s80, s2, 16000
    s_add_u32 s28, s18, 4096
    s_addc_u32 s29, s19, 0
    s_mov_b32 s30, 4000000
    s_mov_b32 s31, 0x20000
    s_add_u32 s24, s28, s80
    s_addc_u32 s25, s29, 0
    s_mov_b32 s26, 16000
    s_mov_b32 s27, 0x20000
    s_cmp_lt_u32 s3, 125
    s_cbranch_scc0 k_cons
    s_mov_b64 exec, s[52:53]
    s_cbranch_execz k_ns
    global_load_dwordx4 v[20:23], v100, s[6:7] nt
    global_load_dwordx4 v[24:27], v98, s[6:7] nt
k_ns:
    s_mov_b64 exec, -1
    v_lshrrev_b32 v99, 3, v0
    v_mul_u32_u24 v98, 144, v99
    v_and_b32 v100, 0x70, v1
    v_add_u32 v98, v98, v100
    v_add_u32 v98, 111872, v98
    s_movk_i32 s84, 16000
    v_mad_u32_u24 v100, v99, s84, v100
    s_mov_b32 s80, 85899346
    s_movk_i32 s81, -50
    s_mov_b32 s83, 111872
    v_mov_b32 v102, 36
    s_waitcnt lgkmcnt(0)
    s_add_u32 s37, s37, 0x100
    s_and_b32 s37, s37, 0xff00
    s_or_b32 s82, s37, 1073676288
    v_mov_b32 v84, s82
    v_mov_b32 v85, s82
    v_mov_b32 v86, s82
    v_mov_b32 v87, s82
    ds_write_b128 v98, v[84:87] offset:0
    ds_write_b128 v98, v[84:87] offset:9216
    ds_write_b128 v98, v[84:87] offset:18432
    ds_write_b128 v98, v[84:87] offset:27648
    s_waitcnt lgkmcnt(0)
    v_mov_b32 v105, 0
    s_mov_b64 exec, 1
    ds_add_u32 v105, v101 offset:276
    s_mov_b64 exec, -1
ss_1:
    ds_read_b32 v106, v105 offset:276
    s_waitcnt lgkmcnt(0)
    v_cmp_gt_u32 vcc, 32, v106
    s_cbranch_vccnz ss_1
    s_mov_b64 exec, s[52:53]
    s_cbranch_execz k_binned
    s_waitcnt vmcnt(2)
    v_mul_hi_u32 v28, v12, s80
    v_lshlrev_b32 v28, 2, v28
    ds_add_rtn_u32 v36, v28, v101 offset:512
    v_mul_hi_u32 v29, v13, s80
    v_lshlrev_b32 v29, 2, v29
    ds_add_rtn_u32 v37, v29, v101 offset:512
    v_mul_hi_u32 v30, v14, s80
    v_lshlrev_b32 v30, 2, v30
    ds_add_rtn_u32 v38, v30, v101 offset:512
    v_mul_hi_u32 v31, v15, s80
    v_lshlrev_b32 v31, 2, v31
    ds_add_rtn_u32 v39, v31, v101 offset:512
    v_mul_hi_u32 v32, v16, s80
    v_lshlrev_b32 v32, 2, v32
    ds_add_rtn_u32 v40, v32, v101 offset:512
    v_mul_hi_u32 v33, v17, s80
    v_lshlrev_b32 v33, 2, v33
    ds_add_rtn_u32 v41, v33, v101 offset:512
    v_mul_hi_u32 v34, v18, s80
    v_lshlrev_b32 v34, 2, v34
    ds_add_rtn_u32 v42, v34, v101 offset:512
    v_mul_hi_u32 v35, v19, s80
    v_lshlrev_b32 v35, 2, v35
    ds_add_rtn_u32 v43, v35, v101 offset:512
    s_waitcnt vmcnt(0)
    v_lshl_add_u32 v20, v20, 14, v12
    v_lshl_add_u32 v20, v20, 2, s37
    v_mad_i32_i24 v20, v28, s81, v20
    v_mad_u32_u24 v44, v28, v102, s83
    v_lshl_add_u32 v21, v21, 14, v13
    v_lshl_add_u32 v21, v21, 2, s37
    v_mad_i32_i24 v21, v29, s81, v21
    v_mad_u32_u24 v45, v29, v102, s83
    v_lshl_add_u32 v22, v22, 14, v14
    v_lshl_add_u32 v22, v22, 2, s37
    v_mad_i32_i24 v22, v30, s81, v22
    v_mad_u32_u24 v46, v30, v102, s83
    v_lshl_add_u32 v23, v23, 14, v15
    v_lshl_add_u32 v23, v23, 2, s37
    v_mad_i32_i24 v23, v31, s81, v23
    v_mad_u32_u24 v47, v31, v102, s83
    v_lshl_add_u32 v24, v24, 14, v16
    v_lshl_add_u32 v24, v24, 2, s37
    v_mad_i32_i24 v24, v32, s81, v24
    v_mad_u32_u24 v48, v32, v102, s83
    v_lshl_add_u32 v25, v25, 14, v17
    v_lshl_add_u32 v25, v25, 2, s37
    v_mad_i32_i24 v25, v33, s81, v25
    v_mad_u32_u24 v49, v33, v102, s83
    v_lshl_add_u32 v26, v26, 14, v18
    v_lshl_add_u32 v26, v26, 2, s37
    v_mad_i32_i24 v26, v34, s81, v26
    v_mad_u32_u24 v50, v34, v102, s83
    v_lshl_add_u32 v27, v27, 14, v19
    v_lshl_add_u32 v27, v27, 2, s37
    v_mad_i32_i24 v27, v35, s81, v27
    v_mad_u32_u24 v51, v35, v102, s83
    s_waitcnt lgkmcnt(0)
    v_max3_u32 v99, v36, v37, v38
    v_max3_u32 v99, v99, v39, v40
    v_max3_u32 v99, v99, v41, v42
    v_max_u32 v99, v99, v43
    v_cmp_le_u32 vcc, 128, v99
    v_add_u32 v44, v36, v44
    v_add_u32 v45, v37, v45
    v_add_u32 v46, v38, v46
    v_add_u32 v47, v39, v47
    v_add_u32 v48, v40, v48
    v_add_u32 v49, v41, v49
    v_add_u32 v50, v42, v50
    v_add_u32 v51, v43, v51
    s_cbranch_vccnz k_slow
    ds_write_b32 v44, v20
    ds_write_b32 v45, v21
    ds_write_b32 v46, v22
    ds_write_b32 v47, v23
    ds_write_b32 v48, v24
    ds_write_b32 v49, v25
    ds_write_b32 v50, v26
    ds_write_b32 v51, v27
k_binned:
    s_mov_b64 exec, -1
    v_mov_b32 v99, 288
    s_lshl_b32 s80, s3, 7
    s_add_u32 s81, s80, 1024000
    s_add_u32 s82, s80, 2048000
    s_add_u32 s83, s80, 3072000
    s_waitcnt lgkmcnt(0)
    v_mov_b32 v105, 0
    s_mov_b64 exec, 1
    ds_add_u32 v105, v101 offset:276
    s_mov_b64 exec, -1
ss_2:
    ds_read_b32 v106, v105 offset:276
    s_waitcnt lgkmcnt(0)
    v_cmp_gt_u32 vcc, 64, v106
    s_cbranch_vccnz ss_2
    ds_read_b32 v44, v99
    ds_read_b128 v[12:15], v98 offset:0
    ds_read_b128 v[16:19], v98 offset:9216
    ds_read_b128 v[20:23], v98 offset:18432
    ds_read_b128 v[24:27], v98 offset:27648
    s_waitcnt lgkmcnt(4)
    v_cmp_ne_u32 vcc, 0, v44
    s_cbranch_vccnz k_flag
k_copy:
    s_waitcnt lgkmcnt(3)
    v_xor_b32 v13, 23040, v13
    v_xor_b32 v14, 42752, v14
    v_xor_b32 v15, 15360, v15
    buffer_store_dwordx4 v[12:15], v100, s[28:31], s80 offen sc1
    s_waitcnt lgkmcnt(2)
    v_xor_b32 v17, 23040, v17
    v_xor_b32 v18, 42752, v18
    v_xor_b32 v19, 15360, v19
    buffer_store_dwordx4 v[16:19], v100, s[28:31], s81 offen sc1
    s_waitcnt lgkmcnt(1)
    v_xor_b32 v21, 23040, v21
    v_xor_b32 v22, 42752, v22
    v_xor_b32 v23, 15360, v23
    buffer_store_dwordx4 v[20:23], v100, s[28:31], s82 offen sc1
    s_waitcnt lgkmcnt(0)
    v_xor_b32 v25, 23040, v25
    v_xor_b32 v26, 42752, v26
    v_xor_b32 v27, 15360, v27
    buffer_store_dwordx4 v[24:27], v100, s[28:31], s83 offen sc1
    s_branch k_sorter
k_cons:
    s_waitcnt lgkmcnt(0)
    s_add_u32 s37, s37, 0x100
    s_and_b32 s37, s37, 0xff00
    v_mov_b32 v105, 0
    s_mov_b64 exec, 1
    ds_add_u32 v105, v101 offset:276
    s_mov_b64 exec, -1
ss_3:
    ds_read_b32 v106, v105 offset:276
    s_waitcnt lgkmcnt(0)
    v_cmp_gt_u32 vcc, 32, v106
    s_cbranch_vccnz ss_3
    s_cmp_lg_u32 s36, 7
    s_cbranch_scc1 k_sorter
    v_mov_b32 v99, 0
    s_mov_b64 exec, 1
    global_atomic_add v99, v101, s[16:17]
    s_mov_b64 exec, -1
    s_branch k_sorter
k_aux0:
    s_sub_u32 s80, s36, 8
    s_lshl_b32 s81, s80, 12
    v_lshlrev_b32 v96, 1, v3
    v_xor_b32 v96, v96, v2
    v_lshlrev_b32 v96, 4, v96
    v_lshl_add_u32 v96, v3, 8, v96
    v_add_u32 v96, s81, v96
    s_add_u32 m0, s81, 46336
    v_xor_b32 v97, 0x80, v96
    global_load_lds_dwordx4 v96, s[10:11] offset:0
    global_load_lds_dwordx4 v96, s[10:11] offset:1024
    global_load_lds_dwordx4 v97, s[10:11] offset:2048
    global_load_lds_dwordx4 v97, s[10:11] offset:3072
    s_mov_b32 s72, s4
    s_or_b32 s73, s5, 0x1000000
    s_movk_i32 s74, 12500
    s_mov_b32 s75, 0x20000
    s_add_u32 s32, s14, s42
    s_addc_u32 s33, s15, 0
    s_sub_u32 s34, 3200000, s42
    s_min_u32 s34, s34, 12800
    s_mov_b32 s35, 0x20000
    v_mov_b32 v5, -1
    s_sub_u32 s80, s36, 8
    s_and_b32 s82, s80, 1
    s_lshl_b32 s82, s82, 3
    v_add_u32 v99, s82, v3
    v_xor_b32 v99, v99, v2
    v_lshlrev_b32 v99, 4, v99
    v_lshl_add_u32 v99, v3, 8, v99
    v_xor_b32 v100, 64, v99
    s_lshl_b32 s82, s80, 11
    s_add_u32 m0, s82, 28928
    s_add_u32 s82, s82, s42
    buffer_load_dwordx4 v99, s[20:23], s82 offen lds
    buffer_load_dwordx4 v100, s[20:23], s82 offen offset:1024 lds
    v_and_b32 v99, 3, v0
    v_lshl_add_u32 v92, v3, 2, v99
    v_lshlrev_b32 v92, 4, v92
    v_and_b32 v100, 12, v0
    v_add_u32 v95, v100, v92
    s_lshl_b32 s80, s36, 10
    s_add_u32 s80, s80, 111872
    v_bfe_u32 v94, v0, 3, 1
    v_mul_u32_u24 v94, 272, v94
    v_bfe_u32 v100, v0, 2, 1
    v_lshl_add_u32 v94, v100, 7, v94
    v_lshl_add_u32 v94, v99, 5, v94
    v_add_u32 v94, s80, v94
    v_lshl_add_u32 v93, v99, 1, v94
    v_lshl_add_u32 v93, v3, 3, v93
    s_mov_b32 s44, 0x000f000f
    s_mov_b32 s45, 0x000f000f
    s_lshl_b64 s[46:47], s[44:45], 4
    s_lshl_b64 s[48:49], s[44:45], 8
    s_lshl_b64 s[50:51], s[44:45], 12
    s_mov_b32 s70, 0xbe0293ee
    s_movk_i32 s71, 68
    s_mov_b32 s43, 0
    s_and_b32 s81, s36, 3
    s_lshl_b32 s81, s81, 12
    s_add_u32 s81, s81, 28928
    v_xor_b32 v4, v3, v2
    v_lshlrev_b32 v4, 4, v4
    v_lshl_add_u32 v4, v2, 8, v4
    v_add_u32 v4, s81, v4
    v_xor_b32 v5, 64, v4
    v_xor_b32 v6, 128, v4
    v_xor_b32 v7, 192, v4
    s_bfe_u32 s80, s36, 0x10002
    s_lshl_b32 s81, s80, 3
    v_lshrrev_b32 v98, 2, v2
    v_bfe_u32 v102, v0, 1, 1
    v_add_u32 v102, s81, v102
    v_and_b32 v103, 1, v3
    v_lshl_add_u32 v103, v103, 2, v98
    v_lshlrev_b32 v103, 1, v103
    v_xor_b32 v102, v102, v103
    v_lshl_add_u32 v98, v3, 3, v98
    v_lshlrev_b32 v98, 8, v98
    v_lshl_add_u32 v98, v102, 4, v98
    v_and_b32 v102, 1, v0
    v_lshl_add_u32 v98, v102, 3, v98
    v_add_u32 v98, 46336, v98
    v_xor_b32 v102, 32, v98
    v_xor_b32 v103, 64, v98
    v_xor_b32 v104, 0x60, v98
    s_and_b32 s81, s36, 3
    s_lshl_b32 s82, s81, 4
    s_mul_i32 s81, s81, 4352
    s_lshl_b32 s80, s80, 7
    s_add_u32 s80, s80, s81
    v_mul_u32_u24 v99, 272, v2
    v_and_b32 v100, 1, v3
    v_lshl_add_u32 v99, v100, 5, v99
    v_lshrrev_b32 v100, 1, v3
    v_lshl_add_u32 v99, v100, 4, v99
    v_add_u32 v99, s80, v99
    v_add_u32 v100, s82, v2
    v_cmp_gt_u32 s[52:53], 50, v100
    s_waitcnt vmcnt(0) lgkmcnt(0)
k_aux1:
    s_add_u32 s37, s37, 0x100
    s_and_b32 s37, s37, 0xff00
    v_mov_b32 v105, 0
    s_mov_b64 exec, 1
    ds_add_u32 v105, v101 offset:272
    s_mov_b64 exec, -1
ss_4:
    ds_read_b32 v106, v105 offset:272
    s_waitcnt lgkmcnt(0)
    v_cmp_gt_u32 vcc, 32, v106
    s_cbranch_vccnz ss_4
    ds_read_b128 v[12:15], v4
    ds_read_b128 v[16:19], v5
    ds_read_b128 v[20:23], v6
    ds_read_b128 v[24:27], v7
    ds_read_b64_tr_b16 v[28:29], v98 offset:0
    ds_read_b64_tr_b16 v[30:31], v98 offset:1024
    ds_read_b64_tr_b16 v[32:33], v98 offset:8192
    ds_read_b64_tr_b16 v[34:35], v98 offset:9216
    ds_read_b64_tr_b16 v[36:37], v98 offset:16384
    ds_read_b64_tr_b16 v[38:39], v98 offset:17408
    ds_read_b64_tr_b16 v[40:41], v98 offset:24576
    ds_read_b64_tr_b16 v[42:43], v98 offset:25600
    ds_read_b64_tr_b16 v[44:45], v102 offset:0
    ds_read_b64_tr_b16 v[46:47], v102 offset:1024
    ds_read_b64_tr_b16 v[48:49], v102 offset:8192
    ds_read_b64_tr_b16 v[50:51], v102 offset:9216
    ds_read_b64_tr_b16 v[52:53], v102 offset:16384
    ds_read_b64_tr_b16 v[54:55], v102 offset:17408
    ds_read_b64_tr_b16 v[56:57], v102 offset:24576
    ds_read_b64_tr_b16 v[58:59], v102 offset:25600
    s_waitcnt lgkmcnt(0)
    s_mov_b64 exec, 1
    ds_add_u32 v105, v101 offset:272
    s_mov_b64 exec, -1
    ds_read_b64_tr_b16 v[60:61], v103 offset:0
    ds_read_b64_tr_b16 v[62:63], v103 offset:1024
    ds_read_b64_tr_b16 v[64:65], v103 offset:8192
    ds_read_b64_tr_b16 v[66:67], v103 offset:9216
    ds_read_b64_tr_b16 v[68:69], v103 offset:16384
    ds_read_b64_tr_b16 v[70:71], v103 offset:17408
    ds_read_b64_tr_b16 v[72:73], v103 offset:24576
    ds_read_b64_tr_b16 v[74:75], v103 offset:25600
    ds_read_b64_tr_b16 v[76:77], v104 offset:0
    ds_read_b64_tr_b16 v[78:79], v104 offset:1024
    ds_read_b64_tr_b16 v[80:81], v104 offset:8192
    ds_read_b64_tr_b16 v[82:83], v104 offset:9216
    ds_read_b64_tr_b16 v[84:85], v104 offset:16384
    ds_read_b64_tr_b16 v[86:87], v104 offset:17408
    ds_read_b64_tr_b16 v[88:89], v104 offset:24576
    ds_read_b64_tr_b16 v[90:91], v104 offset:25600
    v_mfma_f32_16x16x32_bf16 v[4:7], v[28:31], v[12:15], 0
    v_mfma_f32_16x16x32_bf16 v[8:11], v[44:47], v[12:15], 0
    v_mfma_f32_16x16x32_bf16 v[4:7], v[32:35], v[16:19], v[4:7]
    v_mfma_f32_16x16x32_bf16 v[8:11], v[48:51], v[16:19], v[8:11]
    v_mfma_f32_16x16x32_bf16 v[4:7], v[36:39], v[20:23], v[4:7]
    v_mfma_f32_16x16x32_bf16 v[8:11], v[52:55], v[20:23], v[8:11]
    v_mfma_f32_16x16x32_bf16 v[4:7], v[40:43], v[24:27], v[4:7]
    v_mfma_f32_16x16x32_bf16 v[8:11], v[56:59], v[24:27], v[8:11]
    s_nop 6
    v_cvt_pk_bf16_f32 v4, v4, v5
    v_cvt_pk_bf16_f32 v5, v6, v7
    v_cvt_pk_bf16_f32 v6, v8, v9
    v_cvt_pk_bf16_f32 v7, v10, v11
    s_nop 1
    v_permlane16_swap_b32 v4, v6
    v_permlane16_swap_b32 v5, v7
    s_mov_b64 exec, s[52:53]
    ds_write_b128 v99, v[4:7] offset:15136
    s_mov_b64 exec, -1
    s_waitcnt lgkmcnt(1)
    v_mfma_f32_16x16x32_bf16 v[4:7], v[60:63], v[12:15], 0
    v_mfma_f32_16x16x32_bf16 v[8:11], v[76:79], v[12:15], 0
    v_mfma_f32_16x16x32_bf16 v[4:7], v[64:67], v[16:19], v[4:7]
    v_mfma_f32_16x16x32_bf16 v[8:11], v[80:83], v[16:19], v[8:11]
    v_mfma_f32_16x16x32_bf16 v[4:7], v[68:71], v[20:23], v[4:7]
    v_mfma_f32_16x16x32_bf16 v[8:11], v[84:87], v[20:23], v[8:11]
    v_mfma_f32_16x16x32_bf16 v[4:7], v[72:75], v[24:27], v[4:7]
    v_mfma_f32_16x16x32_bf16 v[8:11], v[88:91], v[24:27], v[8:11]
    s_nop 6
    v_cvt_pk_bf16_f32 v4, v4, v5
    v_cvt_pk_bf16_f32 v5, v6, v7
    v_cvt_pk_bf16_f32 v6, v8, v9
    v_cvt_pk_bf16_f32 v7, v10, v11
    s_nop 1
    v_permlane16_swap_b32 v4, v6
    v_permlane16_swap_b32 v5, v7
    s_mov_b64 exec, s[52:53]
    ds_write_b128 v99, v[4:7] offset:15200
    s_mov_b64 exec, -1
    s_mov_b64 exec, 1
    ds_add_u32 v105, v101 offset:284
    s_mov_b64 exec, -1
    v_mov_b32 v8, 1073676540
    v_mov_b32 v9, 1073676540
    v_mov_b32 v10, 1073676540
    v_mov_b32 v11, 1073676540
    v_and_b32 v99, 0x1fff, v1
k_as2:
    ds_read_b32 v106, v105 offset:272
    s_waitcnt lgkmcnt(0)
    v_cmp_gt_u32 vcc, 64, v106
    s_cbranch_vccnz k_as2
    ds_write_b128 v99, v[8:11] offset:28928
    ds_write_b128 v99, v[8:11] offset:37120
    s_cmp_lg_u32 s36, 8
    s_cbranch_scc1 k_as3
    ds_write_b128 v99, v[8:11] offset:45312
k_as3:
    v_mov_b32 v44, 0
    v_mov_b32 v45, 0
    v_mov_b32 v46, 0
    v_mov_b32 v47, 0
    v_mov_b32 v48, 0
    v_mov_b32 v49, 0
    v_mov_b32 v50, 0
    v_mov_b32 v51, 0
    v_mov_b32 v52, 0
    v_mov_b32 v53, 0
    v_mov_b32 v54, 0
    v_mov_b32 v55, 0
    v_mov_b32 v56, 0
    v_mov_b32 v57, 0
    v_mov_b32 v58, 0
    v_mov_b32 v59, 0
    v_mov_b32 v76, 0
    v_mov_b32 v77, 0
    v_mov_b32 v78, 0
    v_mov_b32 v79, 0
    v_mov_b32 v80, 0
    v_mov_b32 v81, 0
    v_mov_b32 v82, 0
    v_mov_b32 v83, 0
    v_mov_b32 v61, v92
    v_mov_b32 v63, v92
    v_mov_b32 v65, v92
    v_mov_b32 v67, v92
    s_sub_u32 s80, s36, 8
    s_lshl_b32 s81, s80, 12
    v_lshlrev_b32 v96, 1, v3
    v_xor_b32 v96, v96, v2
    v_lshlrev_b32 v96, 4, v96
    v_lshl_add_u32 v96, v3, 8, v96
    v_add_u32 v96, s81, v96
    s_add_u32 m0, s81, 79104
    v_xor_b32 v97, 0x80, v96
    global_load_lds_dwordx4 v96, s[12:13] offset:0
    global_load_lds_dwordx4 v96, s[12:13] offset:1024
    global_load_lds_dwordx4 v97, s[12:13] offset:2048
    global_load_lds_dwordx4 v97, s[12:13] offset:3072
    v_mov_b32 v105, 0
k_pc:
    ds_read_b32 v106, v105 offset:280
    s_waitcnt lgkmcnt(0)
    v_cmp_gt_u32 vcc, 32, v106
    s_cbranch_vccnz k_pc
    s_sub_u32 s80, s36, 8
    s_cmp_ge_u32 s80, 3
    s_cselect_b32 s81, 4194304, 0
    s_lshl_b32 s80, s80, 13
    s_add_u32 s80, s80, s81
    s_add_u32 s80, s80, 0
    s_lshr_b32 s81, s2, 3
    s_sub_u32 s81, 31, s81
    s_mul_i32 s81, s81, 24576
    s_add_u32 s80, s80, s81
    v_and_b32 v97, 63, v0
    v_lshlrev_b32 v97, 7, v97
    buffer_load_dword v107, v97, s[20:23], s80 offen
    s_branch k_b1
k_sorter:
    s_mov_b32 s72, s4
    s_or_b32 s73, s5, 0x1000000
    s_movk_i32 s74, 12500
    s_mov_b32 s75, 0x20000
    s_add_u32 s32, s14, s42
    s_addc_u32 s33, s15, 0
    s_sub_u32 s34, 3200000, s42
    s_min_u32 s34, s34, 12800
    s_mov_b32 s35, 0x20000
    v_mov_b32 v5, -1
    v_mov_b32 v8, 0
    v_mov_b32 v9, 0
    v_mov_b32 v10, 0
    v_mov_b32 v11, 0
    ds_write_b128 v1, v[8:11] offset:1536
    v_cmp_gt_u32 vcc, 338, v0
    s_mov_b64 exec, vcc
    ds_write_b128 v1, v[8:11] offset:9728
    s_mov_b64 exec, -1
    v_and_b32 v99, 3, v0
    v_lshl_add_u32 v92, v3, 2, v99
    v_lshlrev_b32 v92, 4, v92
    v_and_b32 v100, 12, v0
    v_add_u32 v95, v100, v92
    s_lshl_b32 s80, s36, 10
    s_add_u32 s80, s80, 111872
    v_bfe_u32 v94, v0, 3, 1
    v_mul_u32_u24 v94, 272, v94
    v_bfe_u32 v100, v0, 2, 1
    v_lshl_add_u32 v94, v100, 7, v94
    v_lshl_add_u32 v94, v99, 5, v94
    v_add_u32 v94, s80, v94
    v_lshl_add_u32 v93, v99, 1, v94
    v_lshl_add_u32 v93, v3, 3, v93
    s_mov_b32 s44, 0x000f000f
    s_mov_b32 s45, 0x000f000f
    s_lshl_b64 s[46:47], s[44:45], 4
    s_lshl_b64 s[48:49], s[44:45], 8
    s_lshl_b64 s[50:51], s[44:45], 12
    s_mov_b32 s70, 0xbe0293ee
    s_movk_i32 s71, 68
    s_mov_b32 s43, 0
    v_mov_b32 v44, 0
    v_mov_b32 v45, 0
    v_mov_b32 v46, 0
    v_mov_b32 v47, 0
    v_mov_b32 v48, 0
    v_mov_b32 v49, 0
    v_mov_b32 v50, 0
    v_mov_b32 v51, 0
    v_mov_b32 v52, 0
    v_mov_b32 v53, 0
    v_mov_b32 v54, 0
    v_mov_b32 v55, 0
    v_mov_b32 v56, 0
    v_mov_b32 v57, 0
    v_mov_b32 v58, 0
    v_mov_b32 v59, 0
    v_mov_b32 v76, 0
    v_mov_b32 v77, 0
    v_mov_b32 v78, 0
    v_mov_b32 v79, 0
    v_mov_b32 v80, 0
    v_mov_b32 v81, 0
    v_mov_b32 v82, 0
    v_mov_b32 v83, 0
    v_mov_b32 v61, v92
    v_mov_b32 v63, v92
    v_mov_b32 v65, v92
    v_mov_b32 v67, v92
    v_mov_b32 v8, 1073676288
    v_mov_b32 v9, 1073676288
    v_mov_b32 v10, 1073676288
    v_mov_b32 v11, 1073676288
    s_mov_b64 s[52:53], -1
    s_movk_i32 s80, 7808
    v_cmp_gt_u32 s[54:55], s80, v1
    s_movk_i32 s80, 8192
    s_mov_b32 s81, 3221290752
    s_mov_b32 s82, 200000
    s_mov_b32 s78, 819200000
    s_xor_b32 s56, s37, 23040
    s_xor_b32 s57, s37, 42752
    s_xor_b32 s58, s37, 15360
    v_mov_b32 v99, 0
k_lg:
    s_sleep 1
    ds_read_b32 v100, v99 offset:284
    s_waitcnt lgkmcnt(0)
    v_cmp_gt_u32 vcc, 32, v100
    s_cbranch_vccnz k_lg
k_lg1:
k_poll:
    s_mov_b64 exec, s[52:53]
    s_cbranch_execz k_p1
    buffer_load_dwordx4 v[4:7], v1, s[24:27], 0 offen sc1
k_p1:
    s_mov_b64 exec, s[54:55]
    s_cbranch_execz k_p2
    buffer_load_dwordx4 v[8:11], v1, s[24:27], s80 offen sc1
k_p2:
    s_mov_b64 exec, -1
    s_sub_u32 s82, s82, 1
    s_cbranch_scc1 k_pto
    s_waitcnt vmcnt(0)
    v_xor_b32 v99, s37, v4
    v_xor_b32 v102, s37, v8
    v_bitop3_b32 v99, v99, v5, s56 bitop3:0xf6
    v_bitop3_b32 v102, v102, v9, s56 bitop3:0xf6
    v_bitop3_b32 v99, v99, v6, s57 bitop3:0xf6
    v_bitop3_b32 v102, v102, v10, s57 bitop3:0xf6
    v_bitop3_b32 v99, v99, v7, s58 bitop3:0xf6
    v_bitop3_b32 v102, v102, v11, s58 bitop3:0xf6
    v_and_b32 v99, s81, v99
    v_and_b32 v102, s81, v102
    v_cmp_ne_u32 s[52:53], 0, v99
    v_cmp_ne_u32 vcc, 0, v102
    s_and_b64 s[54:55], s[54:55], vcc
    s_or_b64 vcc, s[52:53], s[54:55]
    s_cbranch_scc1 k_poll
k_polled:
    v_mov_b32 v99, 0
    s_mov_b64 exec, 1
    ds_add_u32 v99, v101 offset:280
    s_mov_b64 exec, -1
    v_bitop3_b32 v99, v4, v8, 2 bitop3:0xa8
    v_cmp_ne_u32 vcc, 0, v99
    v_cmp_gt_u32 s[52:53], s78, v4
    v_cmp_gt_u32 s[54:55], s78, v5
    v_cmp_gt_u32 s[56:57], s78, v6
    v_cmp_gt_u32 s[58:59], s78, v7
    v_cmp_gt_u32 s[60:61], s78, v8
    v_cmp_gt_u32 s[62:63], s78, v9
    v_cmp_gt_u32 s[64:65], s78, v10
    v_cmp_gt_u32 s[66:67], s78, v11
    s_cbranch_vccnz k_mark
k_round:
    v_and_b32 v12, 0xfc, v4
    v_and_b32 v13, 0xfc, v5
    v_and_b32 v14, 0xfc, v6
    v_and_b32 v15, 0xfc, v7
    v_and_b32 v16, 0xfc, v8
    v_and_b32 v17, 0xfc, v9
    v_and_b32 v18, 0xfc, v10
    v_and_b32 v19, 0xfc, v11
    s_mov_b64 exec, s[52:53]
    ds_add_rtn_u32 v20, v12, v101 offset:0
    s_mov_b64 exec, s[54:55]
    ds_add_rtn_u32 v21, v13, v101 offset:0
    s_mov_b64 exec, s[56:57]
    ds_add_rtn_u32 v22, v14, v101 offset:0
    s_mov_b64 exec, s[58:59]
    ds_add_rtn_u32 v23, v15, v101 offset:0
    s_mov_b64 exec, s[60:61]
    ds_add_rtn_u32 v24, v16, v101 offset:0
    s_mov_b64 exec, s[62:63]
    ds_add_rtn_u32 v25, v17, v101 offset:0
    s_mov_b64 exec, s[64:65]
    ds_add_rtn_u32 v26, v18, v101 offset:0
    s_mov_b64 exec, s[66:67]
    ds_add_rtn_u32 v27, v19, v101 offset:0
    s_mov_b64 exec, -1
k_b1:
    v_and_b32 v99, 63, v0
    v_lshlrev_b32 v99, 2, v99
    v_and_b32 v96, 12, v0
    v_lshlrev_b32 v97, 2, v96
    v_add_u32 v102, 111872, v1
    s_waitcnt lgkmcnt(0)
    s_barrier
    ds_read_b32 v100, v99 offset:0
    ds_read_b32 v103, v96 offset:256
    ds_write_b128 v102, v[76:79]
    s_waitcnt lgkmcnt(1)
    v_add_u32 v100, 12, v100
    v_and_b32 v100, -16, v100
    v_cmp_ne_u32 vcc, 0, v103
    s_cbranch_vccnz k_slowmode
k_sm1:
    v_add_u32_dpp v98, v100, v100 row_shr:1 row_mask:0xf bank_mask:0xf bound_ctrl:0
    s_nop 1
    v_add_u32_dpp v98, v98, v98 row_shr:2 row_mask:0xf bank_mask:0xf bound_ctrl:0
    s_nop 1
    v_add_u32_dpp v98, v98, v98 row_shr:4 row_mask:0xf bank_mask:0xf bound_ctrl:0
    s_nop 1
    v_add_u32_dpp v98, v98, v98 row_shr:8 row_mask:0xf bank_mask:0xf bound_ctrl:0
    s_nop 1
    v_add_u32_dpp v98, v98, v98 row_bcast:15 row_mask:0xa bank_mask:0xf
    s_nop 1
    v_add_u32_dpp v98, v98, v98 row_bcast:31 row_mask:0xc bank_mask:0xf
    s_cmp_ge_u32 s36, 8
    v_sub_u32 v100, v98, v100
    v_readlane_b32 s38, v98, 63
    s_cbranch_scc1 k_nosc
    ds_bpermute_b32 v28, v12, v100
    ds_bpermute_b32 v29, v13, v100
    ds_bpermute_b32 v30, v14, v100
    ds_bpermute_b32 v31, v15, v100
    ds_bpermute_b32 v32, v16, v100
    ds_bpermute_b32 v33, v17, v100
    ds_bpermute_b32 v34, v18, v100
    ds_bpermute_b32 v35, v19, v100
    s_waitcnt lgkmcnt(4)
    v_add_u32 v28, v28, v20
    v_add_u32 v29, v29, v21
    v_add_u32 v30, v30, v22
    v_add_u32 v31, v31, v23
    s_mov_b64 exec, s[52:53]
    ds_write_b32 v28, v4 offset:28928
    s_mov_b64 exec, s[54:55]
    ds_write_b32 v29, v5 offset:28928
    s_mov_b64 exec, s[56:57]
    ds_write_b32 v30, v6 offset:28928
    s_mov_b64 exec, s[58:59]
    ds_write_b32 v31, v7 offset:28928
    s_mov_b64 exec, -1
    s_waitcnt lgkmcnt(4)
    v_add_u32 v32, v32, v24
    v_add_u32 v33, v33, v25
    v_add_u32 v34, v34, v26
    v_add_u32 v35, v35, v27
    s_mov_b64 exec, s[60:61]
    ds_write_b32 v32, v8 offset:28928
    s_mov_b64 exec, s[62:63]
    ds_write_b32 v33, v9 offset:28928
    s_mov_b64 exec, s[64:65]
    ds_write_b32 v34, v10 offset:28928
    s_mov_b64 exec, s[66:67]
    ds_write_b32 v35, v11 offset:28928
    s_mov_b64 exec, -1
k_nosc:
    s_add_u32 s38, s38, 63
    s_lshr_b32 s38, s38, 6
    s_add_u32 s81, s38, 15
    s_mul_i32 s81, s81, 4096
    s_lshr_b32 s81, s81, 16
    s_mul_i32 s82, s81, 16
    s_sub_u32 s82, s82, s38
    s_add_u32 s82, s82, s36
    s_mul_i32 s80, s36, s81
    s_sub_u32 s83, s82, 16
    s_cselect_b32 s83, 0, s83
    s_cselect_b32 s82, 0, 1
    s_sub_u32 s80, s80, s83
    s_sub_u32 s39, s81, s82
    s_cmp_ge_u32 s36, 16
    s_cselect_b32 s39, 0, s39
    s_cselect_b32 s80, 0, s80
    s_lshl_b32 s80, s80, 6
    s_add_u32 s80, s80, 28928
    v_add_u32 v96, s80, v96
    v_add_u32 v97, s80, v97
    v_subrev_u32 v99, 16, v97
    s_mov_b32 s0, 46
    s_mov_b32 s1, 0
    s_setprio 3
    s_waitcnt vmcnt(1) lgkmcnt(0)
    s_barrier
    s_cmp_eq_u32 s39, 0
    s_cbranch_scc1 k_zero
    ds_read_u16 v60, v96 offset:2
    ds_read_u16 v62, v96 offset:18
    ds_read_u16 v64, v96 offset:34
    ds_read_u16 v66, v96 offset:50
    ds_read_u8 v68, v97 offset:0
    ds_read_u8 v69, v97 offset:16
    ds_read_u8 v99, v99
    s_waitcnt lgkmcnt(3)
    buffer_load_dwordx4 v[12:15], v[60:61], s[72:75], 0 idxen offen
    buffer_load_dwordx4 v[16:19], v[62:63], s[72:75], 0 idxen offen
    buffer_load_dwordx4 v[20:23], v[64:65], s[72:75], 0 idxen offen
    buffer_load_dwordx4 v[24:27], v[66:67], s[72:75], 0 idxen offen
    s_cmp_lt_u32 s39, 2
    s_cbranch_scc1 k_pro
    ds_read_u16 v60, v96 offset:66
    ds_read_u16 v62, v96 offset:82
    ds_read_u16 v64, v96 offset:98
    ds_read_u16 v66, v96 offset:114
    ds_read_u8 v70, v97 offset:64
    ds_read_u8 v71, v97 offset:80
    s_waitcnt lgkmcnt(2)
    buffer_load_dwordx4 v[28:31], v[60:61], s[72:75], 0 idxen offen
    buffer_load_dwordx4 v[32:35], v[62:63], s[72:75], 0 idxen offen
    buffer_load_dwordx4 v[36:39], v[64:65], s[72:75], 0 idxen offen
    buffer_load_dwordx4 v[40:43], v[66:67], s[72:75], 0 idxen offen
k_pro:
    v_add_u32 v96, 128, v96
    v_add_u32 v97, 128, v97
    s_waitcnt lgkmcnt(0)
    v_mad_u32_u24 v98, v68, s71, v92
    s_mov_b64 exec, s[44:45]
    ds_read_b128 v[44:47], v98 offset:15136
    s_mov_b64 exec, s[46:47]
    ds_read_b128 v[48:51], v98 offset:15136
    s_mov_b64 exec, s[48:49]
    ds_read_b128 v[52:55], v98 offset:15136
    s_mov_b64 exec, s[50:51]
    ds_read_b128 v[56:59], v98 offset:15136
    s_mov_b64 exec, -1
    v_cmp_eq_u32 vcc, v99, v68
    s_and_b32 s76, vcc_lo, 1
    s_cmp_eq_u32 s36, 0
    s_cselect_b32 s76, 0, s76
    s_call_b64 s[68:69], k_prep
k_loop:
    ds_read_u16 v60, v96 offset:2
    ds_read_u16 v62, v96 offset:18
    ds_read_u16 v64, v96 offset:34
    ds_read_u16 v66, v96 offset:50
    s_bitcmp1_b32 s0, s39
    s_cbranch_scc1 ev_5
er_6:
    s_waitcnt vmcnt(4) lgkmcnt(4)
    v_mfma_f32_16x16x32_bf16 v[72:75], v[44:47], v[12:15], 0
    v_mfma_f32_16x16x32_bf16 v[72:75], v[48:51], v[16:19], v[72:75]
    v_mfma_f32_16x16x32_bf16 v[72:75], v[52:55], v[20:23], v[72:75]
    v_mfma_f32_16x16x32_bf16 v[72:75], v[56:59], v[24:27], v[72:75]
    v_cmp_ne_u32 s[40:41], v68, v69
    v_mad_u32_u24 v98, v70, s71, v92
    s_mov_b64 exec, s[44:45]
    ds_read_b128 v[44:47], v98 offset:15136
    s_mov_b64 exec, s[46:47]
    ds_read_b128 v[48:51], v98 offset:15136
    s_mov_b64 exec, s[48:49]
    ds_read_b128 v[52:55], v98 offset:15136
    s_mov_b64 exec, s[50:51]
    ds_read_b128 v[56:59], v98 offset:15136
    s_mov_b64 exec, -1
    v_mov_b32_dpp v99, v72 quad_perm:[0,0,0,0] row_mask:0xf bank_mask:0xf
    v_add_f32_dpp v99, v73, v99 quad_perm:[1,1,1,1] row_mask:0xf bank_mask:0xf
    v_add_f32_dpp v99, v74, v99 quad_perm:[2,2,2,2] row_mask:0xf bank_mask:0xf
    v_add_f32_dpp v99, v75, v99 quad_perm:[3,3,3,3] row_mask:0xf bank_mask:0xf
    v_mul_f32 v99, s70, v99
    v_exp_f32 v99, v99
    s_nop 0
    v_add_f32 v99, 1.0, v99
    v_rcp_f32 v99, v99
    s_nop 0
    v_cvt_pk_bf16_f32 v99, v99, v99
    ds_write_b16 v93, v99
    ds_read_b128 v[84:87], v94
    ds_read_b128 v[88:91], v94 offset:16
    s_waitcnt lgkmcnt(1)
    v_mfma_f32_4x4x4_16b_bf16 v[76:79], v[84:85], v[12:13], v[76:79]
    v_mfma_f32_4x4x4_16b_bf16 v[80:83], v[84:85], v[14:15], v[80:83]
    s_bitcmp1_b32 s40, 0
    s_cbranch_scc1 fl_7
fb_8:
    v_mfma_f32_4x4x4_16b_bf16 v[76:79], v[86:87], v[16:17], v[76:79]
    v_mfma_f32_4x4x4_16b_bf16 v[80:83], v[86:87], v[18:19], v[80:83]
    s_bitcmp1_b32 s40, 4
    s_cbranch_scc1 fl_9
fb_10:
    s_waitcnt lgkmcnt(0)
    v_mfma_f32_4x4x4_16b_bf16 v[76:79], v[88:89], v[20:21], v[76:79]
    v_mfma_f32_4x4x4_16b_bf16 v[80:83], v[88:89], v[22:23], v[80:83]
    s_bitcmp1_b32 s40, 8
    s_cbranch_scc1 fl_11
fb_12:
    v_mfma_f32_4x4x4_16b_bf16 v[76:79], v[90:91], v[24:25], v[76:79]
    v_mfma_f32_4x4x4_16b_bf16 v[80:83], v[90:91], v[26:27], v[80:83]
    s_bitcmp1_b32 s40, 12
    s_cbranch_scc1 fl_13
fb_14:
    s_cmp_le_u32 s39, 2
    s_cbranch_scc1 sk_15
    buffer_load_dwordx4 v[12:15], v[60:61], s[72:75], 0 idxen offen
    buffer_load_dwordx4 v[16:19], v[62:63], s[72:75], 0 idxen offen
    buffer_load_dwordx4 v[20:23], v[64:65], s[72:75], 0 idxen offen
    buffer_load_dwordx4 v[24:27], v[66:67], s[72:75], 0 idxen offen
sk_15:
    s_sub_u32 s39, s39, 1
    s_cmp_eq_u32 s39, 0
    s_cbranch_scc1 k_exit0
    ds_read_u8 v68, v97 offset:0
    ds_read_u8 v69, v97 offset:16
    ds_read_u16 v60, v96 offset:66
    ds_read_u16 v62, v96 offset:82
    ds_read_u16 v64, v96 offset:98
    ds_read_u16 v66, v96 offset:114
    s_bitcmp1_b32 s0, s39
    s_cbranch_scc1 ev_16
er_17:
    s_waitcnt vmcnt(4) lgkmcnt(4)
    v_mfma_f32_16x16x32_bf16 v[72:75], v[44:47], v[28:31], 0
    v_mfma_f32_16x16x32_bf16 v[72:75], v[48:51], v[32:35], v[72:75]
    v_mfma_f32_16x16x32_bf16 v[72:75], v[52:55], v[36:39], v[72:75]
    v_mfma_f32_16x16x32_bf16 v[72:75], v[56:59], v[40:43], v[72:75]
    v_cmp_ne_u32 s[40:41], v70, v71
    v_mad_u32_u24 v98, v68, s71, v92
    s_mov_b64 exec, s[44:45]
    ds_read_b128 v[44:47], v98 offset:15136
    s_mov_b64 exec, s[46:47]
    ds_read_b128 v[48:51], v98 offset:15136
    s_mov_b64 exec, s[48:49]
    ds_read_b128 v[52:55], v98 offset:15136
    s_mov_b64 exec, s[50:51]
    ds_read_b128 v[56:59], v98 offset:15136
    s_mov_b64 exec, -1
    v_mov_b32_dpp v99, v72 quad_perm:[0,0,0,0] row_mask:0xf bank_mask:0xf
    v_add_f32_dpp v99, v73, v99 quad_perm:[1,1,1,1] row_mask:0xf bank_mask:0xf
    v_add_f32_dpp v99, v74, v99 quad_perm:[2,2,2,2] row_mask:0xf bank_mask:0xf
    v_add_f32_dpp v99, v75, v99 quad_perm:[3,3,3,3] row_mask:0xf bank_mask:0xf
    v_mul_f32 v99, s70, v99
    v_exp_f32 v99, v99
    s_nop 0
    v_add_f32 v99, 1.0, v99
    v_rcp_f32 v99, v99
    s_nop 0
    v_cvt_pk_bf16_f32 v99, v99, v99
    ds_write_b16 v93, v99
    ds_read_b128 v[84:87], v94
    ds_read_b128 v[88:91], v94 offset:16
    s_waitcnt lgkmcnt(1)
    v_mfma_f32_4x4x4_16b_bf16 v[76:79], v[84:85], v[28:29], v[76:79]
    v_mfma_f32_4x4x4_16b_bf16 v[80:83], v[84:85], v[30:31], v[80:83]
    s_bitcmp1_b32 s40, 0
    s_cbranch_scc1 fl_18
fb_19:
    v_mfma_f32_4x4x4_16b_bf16 v[76:79], v[86:87], v[32:33], v[76:79]
    v_mfma_f32_4x4x4_16b_bf16 v[80:83], v[86:87], v[34:35], v[80:83]
    s_bitcmp1_b32 s40, 4
    s_cbranch_scc1 fl_20
fb_21:
    s_waitcnt lgkmcnt(0)
    v_mfma_f32_4x4x4_16b_bf16 v[76:79], v[88:89], v[36:37], v[76:79]
    v_mfma_f32_4x4x4_16b_bf16 v[80:83], v[88:89], v[38:39], v[80:83]
    s_bitcmp1_b32 s40, 8
    s_cbranch_scc1 fl_22
fb_23:
    v_mfma_f32_4x4x4_16b_bf16 v[76:79], v[90:91], v[40:41], v[76:79]
    v_mfma_f32_4x4x4_16b_bf16 v[80:83], v[90:91], v[42:43], v[80:83]
    s_bitcmp1_b32 s40, 12
    s_cbranch_scc1 fl_24
fb_25:
    s_cmp_le_u32 s39, 2
    s_cbranch_scc1 sk_26
    buffer_load_dwordx4 v[28:31], v[60:61], s[72:75], 0 idxen offen
    buffer_load_dwordx4 v[32:35], v[62:63], s[72:75], 0 idxen offen
    buffer_load_dwordx4 v[36:39], v[64:65], s[72:75], 0 idxen offen
    buffer_load_dwordx4 v[40:43], v[66:67], s[72:75], 0 idxen offen
sk_26:
    s_sub_u32 s39, s39, 1
    s_cmp_eq_u32 s39, 0
    s_cbranch_scc1 k_exit1
    ds_read_u8 v70, v97 offset:64
    ds_read_u8 v71, v97 offset:80
    v_add_u32 v96, 128, v96
    v_add_u32 v97, 128, v97
    s_branch k_loop
k_exit0:
    v_readlane_b32 s42, v68, 12
    s_branch k_exit
k_exit1:
    v_readlane_b32 s42, v70, 12
k_exit:
    s_bitcmp1_b32 s40, 12
    s_cbranch_scc1 k_done
    s_cmp_ge_u32 s42, 200
    s_cbranch_scc1 k_done
k_tw:
    v_cmp_eq_u32 vcc, 0, v62
    s_cbranch_vccnz k_tw2
    s_mulk_i32 s42, 68
    v_add_f32_dpp v102, v76, v76 row_ror:8 row_mask:0xf bank_mask:0x3
    v_add_f32_dpp v103, v77, v77 row_ror:8 row_mask:0xf bank_mask:0x3
    v_add_f32_dpp v104, v78, v78 row_ror:8 row_mask:0xf bank_mask:0x3
    v_add_f32_dpp v105, v79, v79 row_ror:8 row_mask:0xf bank_mask:0x3
    v_add_f32_dpp v102, v80, v80 row_ror:8 row_mask:0xf bank_mask:0xc
    v_add_f32_dpp v103, v81, v81 row_ror:8 row_mask:0xf bank_mask:0xc
    v_add_f32_dpp v104, v82, v82 row_ror:8 row_mask:0xf bank_mask:0xc
    v_add_f32_dpp v105, v83, v83 row_ror:8 row_mask:0xf bank_mask:0xc
    v_add_u32 v100, s42, v95
    v_add_f32_dpp v106, v102, v102 row_shl:4 row_mask:0xf bank_mask:0x5
    v_add_f32_dpp v107, v103, v103 row_shl:4 row_mask:0xf bank_mask:0x5
    v_add_f32_dpp v106, v104, v104 row_shr:4 row_mask:0xf bank_mask:0xa
    v_add_f32_dpp v107, v105, v105 row_shr:4 row_mask:0xf bank_mask:0xa
    s_or_b32 s80, s43, s76
    v_add_f32 v106, v106, v60
    v_add_f32 v107, v107, v61
    s_cbranch_scc1 k_tl2
    v_cvt_pk_bf16_f32 v106, v106, v107
    ds_write_b32 v100, v106 offset:1536
k_done:
    s_setprio 0
    s_cmp_lg_u32 s2, 249
    s_cbranch_scc1 k_ne1
    v_mov_b32 v96, 0
    global_load_dword v97, v96, s[16:17] sc1
k_ne1:
    v_xor_b32 v100, 32, v6
    ds_read_b64_tr_b16 v[12:13], v6 offset:24576
    ds_read_b64_tr_b16 v[14:15], v6 offset:25600
    ds_read_b64_tr_b16 v[16:17], v100 offset:24576
    ds_read_b64_tr_b16 v[18:19], v100 offset:25600
    s_cmp_lg_u32 s43, 0
    s_waitcnt lgkmcnt(4)
    s_barrier
    s_cbranch_scc1 k_extra
k_epi:
    ds_read_b128 v[44:47], v4 offset:1536
    ds_read_b128 v[48:51], v4 offset:1600
    ds_read_b128 v[52:55], v4 offset:1664
    ds_read_b128 v[56:59], v4 offset:1728
    s_waitcnt lgkmcnt(3)
    v_mfma_f32_16x16x32_bf16 v[76:79], v[8:11], v[44:47], 0
    v_mfma_f32_16x16x32_bf16 v[80:83], v[108:111], v[44:47], 0
    s_waitcnt lgkmcnt(2)
    v_mfma_f32_16x16x32_bf16 v[76:79], v[112:115], v[48:51], v[76:79]
    v_mfma_f32_16x16x32_bf16 v[80:83], v[116:119], v[48:51], v[80:83]
    s_waitcnt lgkmcnt(1)
    v_mfma_f32_16x16x32_bf16 v[76:79], v[120:123], v[52:55], v[76:79]
    v_mfma_f32_16x16x32_bf16 v[80:83], v[124:127], v[52:55], v[80:83]
    s_waitcnt lgkmcnt(0)
    v_mfma_f32_16x16x32_bf16 v[76:79], v[12:15], v[56:59], v[76:79]
    v_mfma_f32_16x16x32_bf16 v[80:83], v[16:19], v[56:59], v[80:83]
    s_nop 6
    v_cvt_pk_bf16_f32 v20, v76, v77
    v_cvt_pk_bf16_f32 v21, v78, v79
    v_cvt_pk_bf16_f32 v22, v80, v81
    v_cvt_pk_bf16_f32 v23, v82, v83
    s_nop 1
    v_permlane16_swap_b32 v20, v22
    v_permlane16_swap_b32 v21, v23
    buffer_store_dwordx4 v[20:23], v5, s[32:35], 0 offen sc1
    s_cmp_lg_u32 s2, 249
    s_cbranch_scc1 k_fin
    s_cmp_lg_u32 s36, 15
    s_cbranch_scc1 k_fin
    s_mov_b32 s82, 200000
    s_waitcnt vmcnt(1)
k_ep:
    v_readfirstlane_b32 s80, v97
    s_cmp_ge_u32 s80, 500
    s_cbranch_scc1 k_ep2
    s_sub_u32 s82, s82, 1
    s_cbranch_scc1 k_ep2
    global_load_dword v97, v96, s[16:17] sc1
    s_waitcnt vmcnt(0)
    s_branch k_ep
k_ep2:
    v_mov_b32 v97, s37
    s_mov_b64 exec, 1
    global_store_dword v96, v97, s[18:19] offset:0
    s_mov_b64 exec, -1
k_fin:
k_end:
    s_endpgm
fl_7:
    v_readlane_b32 s42, v68, 0
    s_call_b64 s[68:69], k_flush
    s_branch fb_8
fl_9:
    v_readlane_b32 s42, v68, 4
    s_call_b64 s[68:69], k_flush
    s_branch fb_10
fl_11:
    v_readlane_b32 s42, v68, 8
    s_call_b64 s[68:69], k_flush
    s_branch fb_12
fl_13:
    v_readlane_b32 s42, v68, 12
    s_call_b64 s[68:69], k_flush
    s_branch fb_14
fl_18:
    v_readlane_b32 s42, v70, 0
    s_call_b64 s[68:69], k_flush
    s_branch fb_19
fl_20:
    v_readlane_b32 s42, v70, 4
    s_call_b64 s[68:69], k_flush
    s_branch fb_21
fl_22:
    v_readlane_b32 s42, v70, 8
    s_call_b64 s[68:69], k_flush
    s_branch fb_23
fl_24:
    v_readlane_b32 s42, v70, 12
    s_call_b64 s[68:69], k_flush
    s_branch fb_25
k_flush:
    s_nop 0
    s_mulk_i32 s42, 68
    v_add_f32_dpp v102, v76, v76 row_ror:8 row_mask:0xf bank_mask:0x3
    v_add_f32_dpp v103, v77, v77 row_ror:8 row_mask:0xf bank_mask:0x3
    v_add_f32_dpp v104, v78, v78 row_ror:8 row_mask:0xf bank_mask:0x3
    v_add_f32_dpp v105, v79, v79 row_ror:8 row_mask:0xf bank_mask:0x3
    v_add_f32_dpp v102, v80, v80 row_ror:8 row_mask:0xf bank_mask:0xc
    v_add_f32_dpp v103, v81, v81 row_ror:8 row_mask:0xf bank_mask:0xc
    v_add_f32_dpp v104, v82, v82 row_ror:8 row_mask:0xf bank_mask:0xc
    v_add_f32_dpp v105, v83, v83 row_ror:8 row_mask:0xf bank_mask:0xc
    v_add_u32 v100, s42, v95
    v_add_f32_dpp v106, v102, v102 row_shl:4 row_mask:0xf bank_mask:0x5
    v_add_f32_dpp v107, v103, v103 row_shl:4 row_mask:0xf bank_mask:0x5
    v_add_f32_dpp v106, v104, v104 row_shr:4 row_mask:0xf bank_mask:0xa
    v_add_f32_dpp v107, v105, v105 row_shr:4 row_mask:0xf bank_mask:0xa
    s_or_b32 s80, s43, s76
    s_cbranch_scc1 k_flush2
    v_cvt_pk_bf16_f32 v106, v106, v107
    ds_write_b32 v100, v106 offset:1536
k_flush4:
    v_mov_b32 v76, 0
    v_mov_b32 v77, 0
    v_mov_b32 v78, 0
    v_mov_b32 v79, 0
    v_mov_b32 v80, 0
    v_mov_b32 v81, 0
    v_mov_b32 v82, 0
    v_mov_b32 v83, 0
    s_setpc_b64 s[68:69]
k_flush2:
    s_cmp_lg_u32 s76, 0
    s_cbranch_scc1 k_flush5
    v_lshlrev_b32 v100, 1, v100
    v_add_u32 v100, 46336, v100
    ds_read_b64 v[102:103], v100
    s_waitcnt lgkmcnt(0)
    v_add_f32 v106, v106, v102
    v_add_f32 v107, v107, v103
    ds_write_b64 v100, v[106:107]
    s_branch k_flush4
k_flush5:
    s_lshl_b32 s80, s36, 9
    s_add_u32 s80, s80, 128256
    v_lshl_add_u32 v100, v95, 1, s80
    s_lshl_b32 s80, s36, 2
    v_mov_b32 v102, s80
    ds_write_b64 v100, v[106:107]
    ds_write_b32 v102, v101 offset:320
    s_mov_b32 s76, 0
    s_branch k_flush4
ev_5:
    s_call_b64 s[68:69], k_event
    s_branch er_6
ev_16:
    s_call_b64 s[68:69], k_event
    s_branch er_17
k_event:
    s_cmp_le_u32 s39, 2
    s_cselect_b32 s1, 1, 0
    s_cmp_lg_u32 s39, 5
    s_cbranch_scc1 pe_27
    s_setprio 2
pe_27:
    s_cmp_lg_u32 s39, 3
    s_cbranch_scc1 pe_28
    s_setprio 1
pe_28:
    s_cmp_lg_u32 s39, 1
    s_cbranch_scc1 pe_29
    s_setprio 0
pe_29:
    s_cmp_lg_u32 s39, 1
    s_cbranch_scc1 k_ev1
k_ev2:
    s_lshl_b32 s80, s36, 2
    v_mov_b32 v99, s80
    s_lshl_b32 s80, s36, 9
    s_add_u32 s80, s80, 128768
    v_lshl_add_u32 v100, v95, 1, s80
    ds_read_b32 v62, v99 offset:324
    ds_read_b64 v[60:61], v100
    s_waitcnt vmcnt(0) lgkmcnt(2)
k_ev1:
    s_setpc_b64 s[68:69]
k_tl2:
    s_call_b64 s[68:69], k_flush2
    s_branch k_done
k_tw2:
    s_call_b64 s[68:69], k_ev2
    s_waitcnt lgkmcnt(0)
    s_branch k_tw
k_zero:
    s_call_b64 s[68:69], k_prep
    s_branch k_done
k_prep:
    s_lshr_b32 s80, s36, 2
    s_lshl_b32 s81, s80, 2
    v_lshrrev_b32 v6, 2, v2
    v_bfe_u32 v102, v0, 1, 1
    v_add_u32 v102, s81, v102
    v_and_b32 v103, 1, v3
    v_lshl_add_u32 v104, v103, 2, v6
    v_lshlrev_b32 v104, 1, v104
    v_xor_b32 v102, v102, v104
    v_lshl_add_u32 v6, v3, 3, v6
    v_lshlrev_b32 v6, 8, v6
    v_lshl_add_u32 v6, v102, 4, v6
    v_and_b32 v102, 1, v0
    v_lshl_add_u32 v6, v102, 3, v6
    v_add_u32 v6, 79104, v6
    v_xor_b32 v102, 32, v6
    ds_read_b64_tr_b16 v[8:9], v6 offset:0
    ds_read_b64_tr_b16 v[10:11], v6 offset:1024
    ds_read_b64_tr_b16 v[108:109], v102 offset:0
    ds_read_b64_tr_b16 v[110:111], v102 offset:1024
    ds_read_b64_tr_b16 v[112:113], v6 offset:8192
    ds_read_b64_tr_b16 v[114:115], v6 offset:9216
    ds_read_b64_tr_b16 v[116:117], v102 offset:8192
    ds_read_b64_tr_b16 v[118:119], v102 offset:9216
    ds_read_b64_tr_b16 v[120:121], v6 offset:16384
    ds_read_b64_tr_b16 v[122:123], v6 offset:17408
    ds_read_b64_tr_b16 v[124:125], v102 offset:16384
    ds_read_b64_tr_b16 v[126:127], v102 offset:17408
    s_and_b32 s82, s36, 3
    s_mul_i32 s81, s82, 4352
    v_mul_u32_u24 v4, 272, v2
    v_lshl_add_u32 v4, v3, 4, v4
    v_add_u32 v4, s81, v4
    s_lshl_b32 s82, s82, 12
    s_lshl_b32 s80, s80, 6
    s_add_u32 s80, s80, s82
    v_lshlrev_b32 v5, 8, v2
    v_lshl_add_u32 v5, v103, 5, v5
    v_lshrrev_b32 v104, 1, v3
    v_lshl_add_u32 v5, v104, 4, v5
    v_add_u32 v5, s80, v5
    s_waitcnt lgkmcnt(0)
    s_setpc_b64 s[68:69]
k_pto:
    s_mov_b64 exec, -1
    s_waitcnt vmcnt(0)
    s_branch k_polled
k_codeend:
k_slow:
    s_add_u32 s60, s18, 4194304
    s_addc_u32 s61, s19, 0
    s_mov_b32 s62, 2101248
    s_mov_b32 s63, 0x20000
    s_mov_b32 s38, 0xff00
    v_mov_b32 v99, 288
    s_mov_b64 exec, s[52:53]
    v_cmp_gt_u32 vcc, 128, v36
    s_and_b64 exec, s[52:53], vcc
    ds_write_b32 v44, v20
    s_andn2_b64 exec, s[52:53], vcc
    s_cbranch_execz ov_30
    ds_add_rtn_u32 v103, v99, v101
    v_lshlrev_b32 v102, 6, v28
    v_bfi_b32 v102, s38, v102, v20
    s_waitcnt lgkmcnt(0)
    buffer_store_dword v102, v103, s[60:63], s79 offen sc1
ov_30:
    s_mov_b64 exec, s[52:53]
    v_cmp_gt_u32 vcc, 128, v37
    s_and_b64 exec, s[52:53], vcc
    ds_write_b32 v45, v21
    s_andn2_b64 exec, s[52:53], vcc
    s_cbranch_execz ov_31
    ds_add_rtn_u32 v103, v99, v101
    v_lshlrev_b32 v102, 6, v29
    v_bfi_b32 v102, s38, v102, v21
    s_waitcnt lgkmcnt(0)
    buffer_store_dword v102, v103, s[60:63], s79 offen sc1
ov_31:
    s_mov_b64 exec, s[52:53]
    v_cmp_gt_u32 vcc, 128, v38
    s_and_b64 exec, s[52:53], vcc
    ds_write_b32 v46, v22
    s_andn2_b64 exec, s[52:53], vcc
    s_cbranch_execz ov_32
    ds_add_rtn_u32 v103, v99, v101
    v_lshlrev_b32 v102, 6, v30
    v_bfi_b32 v102, s38, v102, v22
    s_waitcnt lgkmcnt(0)
    buffer_store_dword v102, v103, s[60:63], s79 offen sc1
ov_32:
    s_mov_b64 exec, s[52:53]
    v_cmp_gt_u32 vcc, 128, v39
    s_and_b64 exec, s[52:53], vcc
    ds_write_b32 v47, v23
    s_andn2_b64 exec, s[52:53], vcc
    s_cbranch_execz ov_33
    ds_add_rtn_u32 v103, v99, v101
    v_lshlrev_b32 v102, 6, v31
    v_bfi_b32 v102, s38, v102, v23
    s_waitcnt lgkmcnt(0)
    buffer_store_dword v102, v103, s[60:63], s79 offen sc1
ov_33:
    s_mov_b64 exec, s[52:53]
    v_cmp_gt_u32 vcc, 128, v40
    s_and_b64 exec, s[52:53], vcc
    ds_write_b32 v48, v24
    s_andn2_b64 exec, s[52:53], vcc
    s_cbranch_execz ov_34
    ds_add_rtn_u32 v103, v99, v101
    v_lshlrev_b32 v102, 6, v32
    v_bfi_b32 v102, s38, v102, v24
    s_waitcnt lgkmcnt(0)
    buffer_store_dword v102, v103, s[60:63], s79 offen sc1
ov_34:
    s_mov_b64 exec, s[52:53]
    v_cmp_gt_u32 vcc, 128, v41
    s_and_b64 exec, s[52:53], vcc
    ds_write_b32 v49, v25
    s_andn2_b64 exec, s[52:53], vcc
    s_cbranch_execz ov_35
    ds_add_rtn_u32 v103, v99, v101
    v_lshlrev_b32 v102, 6, v33
    v_bfi_b32 v102, s38, v102, v25
    s_waitcnt lgkmcnt(0)
    buffer_store_dword v102, v103, s[60:63], s79 offen sc1
ov_35:
    s_mov_b64 exec, s[52:53]
    v_cmp_gt_u32 vcc, 128, v42
    s_and_b64 exec, s[52:53], vcc
    ds_write_b32 v50, v26
    s_andn2_b64 exec, s[52:53], vcc
    s_cbranch_execz ov_36
    ds_add_rtn_u32 v103, v99, v101
    v_lshlrev_b32 v102, 6, v34
    v_bfi_b32 v102, s38, v102, v26
    s_waitcnt lgkmcnt(0)
    buffer_store_dword v102, v103, s[60:63], s79 offen sc1
ov_36:
    s_mov_b64 exec, s[52:53]
    v_cmp_gt_u32 vcc, 128, v43
    s_and_b64 exec, s[52:53], vcc
    ds_write_b32 v51, v27
    s_andn2_b64 exec, s[52:53], vcc
    s_cbranch_execz ov_37
    ds_add_rtn_u32 v103, v99, v101
    v_lshlrev_b32 v102, 6, v35
    v_bfi_b32 v102, s38, v102, v27
    s_waitcnt lgkmcnt(0)
    buffer_store_dword v102, v103, s[60:63], s79 offen sc1
ov_37:
    s_mov_b64 exec, -1
    s_waitcnt vmcnt(0)
    s_branch k_binned
k_flag:
    s_waitcnt lgkmcnt(0)
    v_mov_b32 v105, 0
    s_mov_b64 exec, 1
    ds_add_u32 v105, v101 offset:276
    s_mov_b64 exec, -1
ss_38:
    ds_read_b32 v106, v105 offset:276
    s_waitcnt lgkmcnt(0)
    v_cmp_gt_u32 vcc, 96, v106
    s_cbranch_vccnz ss_38
    s_add_u32 s60, s18, 4194304
    s_addc_u32 s61, s19, 0
    s_mov_b32 s62, 2101248
    s_mov_b32 s63, 0x20000
    v_cmp_gt_u32 vcc, 250, v0
    s_mov_b64 exec, vcc
    v_lshlrev_b32 v102, 2, v0
    ds_read_b32 v103, v102 offset:512
    v_mul_u32_u24 v102, 144, v0
    v_add_u32 v102, 111872, v102
    v_mov_b32 v104, 2
    s_waitcnt lgkmcnt(0)
    v_cmp_lt_u32 vcc, 128, v103
    s_and_b64 exec, exec, vcc
    ds_or_b32 v102, v104
    s_mov_b64 exec, -1
    s_lshl_b32 s84, s3, 2
    s_add_u32 s84, s84, 2097152
    v_mov_b32 v102, 0
    buffer_store_dword v44, v102, s[60:63], s84 offen sc1
    s_waitcnt vmcnt(0) lgkmcnt(0)
    v_mov_b32 v105, 0
    s_mov_b64 exec, 1
    ds_add_u32 v105, v101 offset:276
    s_mov_b64 exec, -1
ss_39:
    ds_read_b32 v106, v105 offset:276
    s_waitcnt lgkmcnt(0)
    v_cmp_gt_u32 vcc, 128, v106
    s_cbranch_vccnz ss_39
    ds_read_b128 v[12:15], v98 offset:0
    ds_read_b128 v[16:19], v98 offset:9216
    ds_read_b128 v[20:23], v98 offset:18432
    ds_read_b128 v[24:27], v98 offset:27648
    s_branch k_copy
k_mark:
    v_and_b32 v99, 2, v4
    v_cmp_ne_u32 vcc, 0, v99
    s_and_b64 exec, vcc, s[52:53]
    v_and_b32 v4, -3, v4
    v_lshrrev_b32 v99, 3, v0
    v_add_u32 v99, 0, v99
    v_lshrrev_b32 v100, 5, v99
    v_lshlrev_b32 v100, 2, v100
    v_and_b32 v99, 31, v99
    v_lshlrev_b32 v99, v99, 1
    ds_or_b32 v100, v99 offset:256
    s_mov_b64 exec, -1
    v_and_b32 v99, 2, v8
    v_cmp_ne_u32 vcc, 0, v99
    s_and_b64 exec, vcc, s[60:61]
    v_and_b32 v8, -3, v8
    v_lshrrev_b32 v99, 3, v0
    v_add_u32 v99, 64, v99
    v_lshrrev_b32 v100, 5, v99
    v_lshlrev_b32 v100, 2, v100
    v_and_b32 v99, 31, v99
    v_lshlrev_b32 v99, v99, 1
    ds_or_b32 v100, v99 offset:256
    s_mov_b64 exec, -1
    s_branch k_round
k_slowmode:
    s_cmp_lg_u32 s43, 0
    s_cbranch_scc1 k_sm1
    s_mov_b32 s43, 1
    v_add_u32 v102, 46336, v1
    ds_write_b128 v102, v[76:79]
    ds_write_b128 v102, v[76:79] offset:16384
    s_branch k_sm1
k_extra:
    v_mov_b32 v99, 0
    ds_read_b128 v[84:87], v99 offset:256
    s_waitcnt lgkmcnt(0)
    v_readfirstlane_b32 s52, v84
    v_readfirstlane_b32 s53, v85
    v_readfirstlane_b32 s54, v86
    v_readfirstlane_b32 s55, v87
    s_barrier
    s_or_b64 s[56:57], s[52:53], s[54:55]
    s_cbranch_scc1 k_x0
    v_lshrrev_b32 v102, 4, v0
    v_and_b32 v103, 0xf0, v1
    v_mul_u32_u24 v102, 272, v102
    v_add_u32 v102, v102, v103
    v_lshlrev_b32 v103, 1, v102
    v_add_u32 v103, 46336, v103
    v_cmp_gt_u32 vcc, 800, v0
    s_mov_b64 exec, vcc
    ds_read_b128 v[44:47], v103
    ds_read_b128 v[48:51], v103 offset:16
    s_waitcnt lgkmcnt(0)
    v_cvt_pk_bf16_f32 v44, v44, v45
    v_cvt_pk_bf16_f32 v45, v46, v47
    v_cvt_pk_bf16_f32 v46, v48, v49
    v_cvt_pk_bf16_f32 v47, v50, v51
    ds_write_b128 v102, v[44:47] offset:1536
    s_mov_b64 exec, -1
    s_waitcnt lgkmcnt(0)
    s_barrier
    s_branch k_epi
k_x0:
    s_cmp_lg_u64 s[52:53], 0
    s_cbranch_scc1 k_x1
    s_ff1_i32_b64 s80, s[54:55]
    s_bitset0_b64 s[54:55], s80
    s_add_u32 s80, s80, 64
    s_branch k_x2
k_x1:
    s_ff1_i32_b64 s80, s[52:53]
    s_bitset0_b64 s[52:53], s80
k_x2:
    s_add_u32 s28, s18, 4194304
    s_addc_u32 s29, s19, 0
    s_mov_b32 s30, 2101248
    s_mov_b32 s31, 0x20000
    s_lshl_b32 s38, s80, 2
    s_add_u32 s38, s38, 2097152
    v_mov_b32 v99, 0
    buffer_load_dword v100, v99, s[28:31], s38 offen sc1
    s_mul_i32 s38, s80, 12800
    buffer_load_dwordx4 v[4:7], v1, s[28:31], s38 offen sc1
    s_add_u32 s38, s38, 8192
    buffer_load_dwordx4 v[8:11], v1, s[28:31], s38 offen sc1
    v_mov_b32 v12, 1073676540
    v_mov_b32 v13, 1073676540
    v_mov_b32 v14, 1073676540
    v_mov_b32 v15, 1073676540
    ds_write_b128 v1, v[12:15] offset:28928
    s_cmp_lg_u32 s36, 0
    s_cbranch_scc1 k_x3
    ds_write_b128 v1, v[12:15] offset:45312
    v_lshrrev_b32 v102, 2, v1
    ds_write_b32 v102, v99 offset:0
    v_and_b32 v102, 0x7c, v102
    ds_write_b32 v102, v99 offset:320
    v_mov_b32 v16, s52
    v_mov_b32 v17, s53
    v_mov_b32 v18, s54
    v_mov_b32 v19, s55
    ds_write_b128 v99, v[16:19] offset:256
k_x3:
    v_mov_b32 v44, 0
    v_mov_b32 v45, 0
    v_mov_b32 v46, 0
    v_mov_b32 v47, 0
    v_mov_b32 v48, 0
    v_mov_b32 v49, 0
    v_mov_b32 v50, 0
    v_mov_b32 v51, 0
    v_mov_b32 v52, 0
    v_mov_b32 v53, 0
    v_mov_b32 v54, 0
    v_mov_b32 v55, 0
    v_mov_b32 v56, 0
    v_mov_b32 v57, 0
    v_mov_b32 v58, 0
    v_mov_b32 v59, 0
    v_mov_b32 v76, 0
    v_mov_b32 v77, 0
    v_mov_b32 v78, 0
    v_mov_b32 v79, 0
    v_mov_b32 v80, 0
    v_mov_b32 v81, 0
    v_mov_b32 v82, 0
    v_mov_b32 v83, 0
    v_mov_b32 v61, v92
    v_mov_b32 v63, v92
    v_mov_b32 v65, v92
    v_mov_b32 v67, v92
    s_waitcnt vmcnt(0)
    v_bfe_u32 v102, v4, 8, 8
    v_cmp_eq_u32 vcc, s2, v102
    v_add_u32 v103, 0, v1
    v_cmp_lt_u32 s[52:53], v103, v100
    s_and_b64 s[52:53], s[52:53], vcc
    v_bfe_u32 v102, v5, 8, 8
    v_cmp_eq_u32 vcc, s2, v102
    v_add_u32 v103, 4, v1
    v_cmp_lt_u32 s[54:55], v103, v100
    s_and_b64 s[54:55], s[54:55], vcc
    v_bfe_u32 v102, v6, 8, 8
    v_cmp_eq_u32 vcc, s2, v102
    v_add_u32 v103, 8, v1
    v_cmp_lt_u32 s[56:57], v103, v100
    s_and_b64 s[56:57], s[56:57], vcc
    v_bfe_u32 v102, v7, 8, 8
    v_cmp_eq_u32 vcc, s2, v102
    v_add_u32 v103, 12, v1
    v_cmp_lt_u32 s[58:59], v103, v100
    s_and_b64 s[58:59], s[58:59], vcc
    v_bfe_u32 v102, v8, 8, 8
    v_cmp_eq_u32 vcc, s2, v102
    v_add_u32 v103, 8192, v1
    v_cmp_lt_u32 s[60:61], v103, v100
    s_and_b64 s[60:61], s[60:61], vcc
    v_bfe_u32 v102, v9, 8, 8
    v_cmp_eq_u32 vcc, s2, v102
    v_add_u32 v103, 8196, v1
    v_cmp_lt_u32 s[62:63], v103, v100
    s_and_b64 s[62:63], s[62:63], vcc
    v_bfe_u32 v102, v10, 8, 8
    v_cmp_eq_u32 vcc, s2, v102
    v_add_u32 v103, 8200, v1
    v_cmp_lt_u32 s[64:65], v103, v100
    s_and_b64 s[64:65], s[64:65], vcc
    v_bfe_u32 v102, v11, 8, 8
    v_cmp_eq_u32 vcc, s2, v102
    v_add_u32 v103, 8204, v1
    v_cmp_lt_u32 s[66:67], v103, v100
    s_and_b64 s[66:67], s[66:67], vcc
    s_waitcnt lgkmcnt(0)
    s_barrier
    s_cmp_lt_u32 s36, 8
    s_cbranch_scc1 k_round
    s_branch k_b1
.section .rodata,"a"
.p2align 6
.amdhsa_kernel standalone__kernel_systems_refs_featgraph__graph_kernel
  .amdhsa_next_free_vgpr 128
  .amdhsa_next_free_sgpr 102
  .amdhsa_accum_offset 128
  .amdhsa_group_segment_fixed_size 0
  .amdhsa_kernarg_size 64
  .amdhsa_user_sgpr_count 2
  .amdhsa_user_sgpr_kernarg_segment_ptr 1
  .amdhsa_system_sgpr_workgroup_id_x 1
.end_amdhsa_kernel
```
